```python
import torch

def _softmax(x, axis=-1):
    return torch.softmax(x, dim=axis)
def _gelu(x):
    return torch.nn.functional.gelu(x, approximate="tanh")
def _silu(x):
    return torch.nn.functional.silu(x)
def _sigmoid(x):
    return torch.sigmoid(x)
def _layernorm(x, axis=-1, eps=1e-5):
    m = x.mean(dim=axis, keepdim=True)
    v = x.var(dim=axis, keepdim=True, unbiased=False)
    return (x - m) / torch.sqrt(v + eps)
def _scatter_add(tgt, idx, src, axis=0):
    return tgt.clone().index_add_(axis, idx, src)
def _segment_sum(src, seg, n):
    out = torch.zeros((n,) + src.shape[1:], dtype=src.dtype)
    return out.index_add_(0, seg, src)
def _pad(x, pw):
    flat = tuple(v for pair in reversed(pw) for v in pair)
    return torch.nn.functional.pad(x, flat)

kernel_name = 'standalone__gqa_softmax__sampling'

def setup_inputs():

    _w = (lambda a: (lambda t: t.to(torch.bfloat16) if t.is_floating_point() else t)(torch.as_tensor(a)))
    B, Hq, Hkv, Sq, Sk, D = 8, 32, 8, 8, 8192, 128
    return {
        "q": _w((lambda *s: torch.randn(*s, dtype=torch.bfloat16) * 0.8)(B, Hq, Sq, D)),
        "k": _w((lambda *s: torch.randn(*s, dtype=torch.bfloat16) * 0.8)(B, Hkv, Sk, D)),
        "v": _w((lambda *s: torch.randn(*s, dtype=torch.bfloat16) * 0.05)(B, Hkv, Sk, D)),
    }

def reference(q, k, v):
    B, Hq, Sq, D = q.shape
    Hkv = k.shape[1]
    rep = Hq // Hkv
    k = (lambda x, n, axis: torch.repeat_interleave(x, n, dim=axis))(k, rep, axis=1)
    v = (lambda x, n, axis: torch.repeat_interleave(x, n, dim=axis))(v, rep, axis=1)
    scale = D ** -0.5
    scores = torch.einsum("bhqd,bhkd->bhqk", q, k) * scale
    p = _softmax(scores, axis=-1)
    return torch.einsum("bhqk,bhkd->bhqd", p, v)
```

```asm
; @launch grid=(256,1,1) block=(256,1,1) lds=149568
.amdgcn_target "amdgcn-amd-amdhsa--gfx950"
.text
.globl standalone__gqa_softmax__sampling_kernel
.p2align 8
.type standalone__gqa_softmax__sampling_kernel,@function
standalone__gqa_softmax__sampling_kernel:
    s_load_dwordx8 s[4:11], s[0:1], 0
    s_load_dwordx4 s[12:15], s[0:1], 32
    s_cmp_ge_u32 s2, 256
    s_cbranch_scc1 L_end
    v_lshrrev_b32 v1, 6, v0
    v_and_b32 v36, 63, v0
    v_readfirstlane_b32 s40, v1
    s_and_b32 s41, s2, 7
    s_lshr_b32 s49, s2, 5
    s_lshl_b32 s49, s49, 3
    s_add_u32 s41, s41, s49
    s_bfe_u32 s42, s2, 0x20003
    v_lshrrev_b32 v37, 4, v36
    v_and_b32 v38, 15, v36
    v_lshlrev_b32 v39, 12, v37
    v_xor_b32 v40, v38, v37
    v_lshl_add_u32 v1, v40, 4, v39
    v_xor_b32 v2, 64, v1
    v_xor_b32 v3, 128, v1
    v_xor_b32 v4, 192, v1
    s_lshl_b32 s43, s40, 15
    s_add_u32 s43, s43, 16384
    s_and_b32 s22, s40, 1
    s_mul_i32 s22, s22, 2304
    s_lshr_b32 s49, s40, 1
    s_mul_i32 s49, s49, 16896
    s_or_b32 s22, s22, s49
    s_and_b32 s49, s42, 1
    s_lshl_b32 s49, s49, 10
    s_or_b32 s22, s22, s49
    s_lshl_b32 s49, s41, 21
    s_lshl_b32 s46, s42, 15
    s_add_u32 s49, s49, s46
    s_lshl_b32 s51, s41, 13
    s_mov_b32 s18, 1998848
    s_mov_b32 s19, 0x20000
    s_mov_b32 s44, s22
    s_mov_b32 m0, s43
    s_waitcnt lgkmcnt(0)
    s_add_u32 s16, s6, s49
    s_addc_u32 s17, s7, 0
    buffer_load_dwordx4 v1, s[16:19], s44 offen nt lds
    s_add_u32 s20, s8, s49
    s_addc_u32 s21, s9, 0
    s_add_u32 s24, s4, s51
    s_addc_u32 s25, s5, 0
    s_load_dword s50, s[24:25], 0
    s_load_dword s50, s[20:21], 0
    s_mov_b32 s0, s43
    s_add_u32 m0, s0, 1024
    s_xor_b32 s46, s44, 1024
    buffer_load_dwordx4 v2, s[16:19], s46 offen nt lds
    s_add_u32 m0, s0, 2048
    s_xor_b32 s46, s44, 2048
    buffer_load_dwordx4 v3, s[16:19], s46 offen nt lds
    s_add_u32 m0, s0, 3072
    s_xor_b32 s46, s44, 3072
    buffer_load_dwordx4 v4, s[16:19], s46 offen nt lds
    s_add_u32 m0, s0, 4096
    s_xor_b32 s46, s44, 16384
    buffer_load_dwordx4 v1, s[16:19], s46 offen nt lds
    s_add_u32 m0, s0, 5120
    s_xor_b32 s46, s44, 17408
    buffer_load_dwordx4 v2, s[16:19], s46 offen nt lds
    s_add_u32 m0, s0, 6144
    s_xor_b32 s46, s44, 18432
    buffer_load_dwordx4 v3, s[16:19], s46 offen nt lds
    s_add_u32 m0, s0, 7168
    s_xor_b32 s46, s44, 19456
    buffer_load_dwordx4 v4, s[16:19], s46 offen nt lds
    s_mov_b32 s26, 8192
    s_mov_b32 s27, 0x20000
    s_lshl_b32 s46, s40, 6
    v_and_b32 v42, 0xff, v1
    v_lshl_add_u32 v42, v37, 8, v42
    v_xor_b32 v42, s46, v42
    v_lshlrev_b32 v40, 2, v37
    v_xor_b32 v40, v38, v40
    v_lshl_add_u32 v5, v40, 4, v39
    s_mul_i32 s49, s41, 49152
    s_add_u32 s28, s14, s49
    s_addc_u32 s29, s15, 0
    s_mov_b32 s30, 49152
    s_mov_b32 s31, 0x20000
    s_add_u32 s32, s10, s51
    s_addc_u32 s33, s11, 0
    s_mov_b32 s34, 8192
    s_mov_b32 s35, 0x20000
    s_mov_b32 s36, s12
    s_mov_b32 s37, s13
    s_mov_b32 s38, 256
    s_mov_b32 s39, 0x20000
    s_mul_i32 s45, s40, 15360
    s_cmp_eq_u32 s42, s40
    s_cselect_b32 s49, 1, 0
    s_xor_b32 s96, s42, s49
    s_xor_b32 s97, s42, 2
    s_xor_b32 s98, s42, 3
    s_lshl_b32 s96, s96, 2
    s_add_u32 s96, s96, s40
    s_mul_i32 s96, s96, 3072
    s_lshl_b32 s97, s97, 2
    s_add_u32 s97, s97, s40
    s_mul_i32 s97, s97, 3072
    s_lshl_b32 s98, s98, 2
    s_add_u32 s98, s98, s40
    s_mul_i32 s98, s98, 3072
    s_buffer_load_dword s52, s[28:31], s96 offset:12
    s_cmp_eq_u32 s42, s40
    s_cbranch_scc0 L_refd
    s_buffer_load_dword s53, s[28:31], s97 offset:12
    s_buffer_load_dword s54, s[28:31], s98 offset:12
L_refd:
    s_getreg_b32 s93, hwreg(HW_REG_XCC_ID, 0, 4)
    v_and_b32 v37, 31, v36
    v_lshrrev_b32 v38, 5, v36
    v_lshlrev_b32 v39, 8, v37
    v_lshl_add_u32 v28, v38, 4, v39
    v_and_b32 v41, 15, v36
    v_xor_b32 v41, v41, v38
    v_lshl_add_u32 v6, v41, 4, v39
    v_xor_b32 v7, 32, v6
    v_xor_b32 v8, 64, v6
    v_xor_b32 v9, 96, v6
    v_xor_b32 v10, 128, v6
    v_xor_b32 v11, 160, v6
    v_xor_b32 v12, 192, v6
    v_xor_b32 v13, 224, v6
    v_lshlrev_b32 v25, 4, v37
    v_add_u32 v25, 147456, v25
    s_lshl_b32 s49, s40, 2
    v_add_u32 v24, s49, v25
    v_lshlrev_b32 v26, 4, v36
    v_add_u32 v27, s49, v26
    v_add_u32 v27, 148480, v27
    v_mov_b32 v29, 149504
    v_add_u32 v30, s49, v29
    v_mov_b32 v17, v26
    s_lshl_b32 s49, s40, 11
    v_add_u32 v16, s49, v26
    v_bfe_u32 v37, v36, 2, 2
    v_lshl_add_u32 v39, v38, 2, v37
    v_lshlrev_b32 v39, 8, v39
    v_xor_b32 v37, s40, v37
    v_lshl_add_u32 v39, v37, 6, v39
    v_bfe_u32 v40, v36, 4, 1
    v_lshl_add_u32 v39, v40, 5, v39
    v_and_b32 v40, 3, v36
    v_lshl_add_u32 v39, v40, 3, v39
    v_add_u32 v14, 16384, v39
    v_add_u32 v15, 81920, v39
    v_mov_b32 v18, 0xff7fffff
    v_mov_b32 v19, 0
    ds_write_b32 v30, v19
    s_mov_b32 s48, 0x3e0293ee
    s_mov_b32 s47, 0
    s_mov_b32 s100, 0
    s_add_u32 s80, s14, 3211264
    s_addc_u32 s81, s15, 0
    s_mov_b32 s82, 139264
    s_mov_b32 s83, 0x20000
    s_load_dword s7, s[14:15], 12300
    s_mov_b32 s59, s2
    s_mov_b32 s101, 0
    s_cmp_eq_u32 s40, 0
    s_cselect_b32 s86, 32, 0
    s_lshr_b32 s87, s2, 3
    s_mul_i32 s49, s40, 3
    s_add_u32 s87, s87, s49
    s_mul_i32 s88, s40, 34816
    s_mov_b32 s6, 99
    s_mov_b32 s85, 99
    s_mov_b32 s89, 0x15554104
    s_mov_b32 s12, 0x1177ffff
    s_mov_b32 s13, 0x0
    s_mov_b32 s10, 0xff
    s_lshl_b32 s49, s40, 10
    s_mov_b32 m0, s49
    s_add_u32 s46, s49, 4096
    s_waitcnt vmcnt(6)
    buffer_load_dwordx4 v42, s[24:27], s49 offen lds
    s_mov_b32 m0, s46
    s_add_u32 s44, s44, 131072
    s_add_u32 s100, s100, 8192
    s_and_b32 s100, s100, 0x6000
    s_add_u32 s0, s43, s100
    buffer_load_dwordx4 v42, s[24:27], s46 offen lds
    s_add_u32 m0, s0, 0
    s_xor_b32 s46, s44, 0
    s_waitcnt vmcnt(6)
    buffer_load_dwordx4 v1, s[16:19], s46 offen nt lds
    s_add_u32 m0, s0, 1024
    s_xor_b32 s46, s44, 1024
    s_waitcnt vmcnt(6)
    buffer_load_dwordx4 v2, s[16:19], s46 offen nt lds
    s_add_u32 m0, s0, 2048
    s_xor_b32 s46, s44, 2048
    s_waitcnt vmcnt(6)
    buffer_load_dwordx4 v3, s[16:19], s46 offen nt lds
    s_add_u32 m0, s0, 3072
    s_xor_b32 s46, s44, 3072
    s_waitcnt vmcnt(6)
    buffer_load_dwordx4 v4, s[16:19], s46 offen nt lds
    s_add_u32 m0, s0, 4096
    s_xor_b32 s46, s44, 16384
    s_waitcnt vmcnt(6)
    buffer_load_dwordx4 v1, s[16:19], s46 offen nt lds
    s_add_u32 m0, s0, 5120
    s_xor_b32 s46, s44, 17408
    s_waitcnt vmcnt(6)
    buffer_load_dwordx4 v2, s[16:19], s46 offen nt lds
    s_add_u32 m0, s0, 6144
    s_xor_b32 s46, s44, 18432
    s_waitcnt vmcnt(6)
    buffer_load_dwordx4 v3, s[16:19], s46 offen nt lds
    s_add_u32 m0, s0, 7168
    s_xor_b32 s46, s44, 19456
    s_waitcnt vmcnt(6)
    buffer_load_dwordx4 v4, s[16:19], s46 offen nt lds
    s_add_u32 s44, s44, 131072
    s_add_u32 s100, s100, 8192
    s_and_b32 s100, s100, 0x6000
    s_add_u32 s0, s43, s100
    s_waitcnt vmcnt(8)
    s_barrier
    ds_read_b128 a[0:3], v6
    ds_read_b128 a[4:7], v7
    ds_read_b128 a[8:11], v8
    ds_read_b128 a[12:15], v9
    ds_read_b128 a[16:19], v10
    ds_read_b128 a[20:23], v11
    ds_read_b128 a[24:27], v12
    ds_read_b128 a[28:31], v13
    v_add_u32 v6, s43, v6
    v_add_u32 v7, s43, v7
    v_add_u32 v8, s43, v8
    v_add_u32 v9, s43, v9
    v_add_u32 v10, s43, v10
    v_add_u32 v11, s43, v11
    v_add_u32 v12, s43, v12
    v_add_u32 v13, s43, v13
    s_waitcnt lgkmcnt(0)
    s_cmp_eq_u32 s42, s40
    s_cbranch_scc0 L_noecho
    s_xor_b32 s49, s52, 0x5bd1e995
    v_mov_b32 v32, s49
    s_xor_b32 s49, s53, 0x5bd1e995
    v_mov_b32 v33, s49
    s_xor_b32 s49, s54, 0x5bd1e995
    v_mov_b32 v34, s49
    v_mov_b32 v35, s93
    s_mov_b64 exec, 1
    buffer_store_dwordx4 v[32:35], off, s[28:31], s45 sc1
    s_mov_b64 exec, -1
    s_add_u32 s53, s53, 1
    s_add_u32 s54, s54, 1
L_noecho:
    s_add_u32 s52, s52, 1
    s_add_u32 s7, s7, 1
    v_lshlrev_b32 v41, 18, v36
    v_mov_b32 v42, s7
L_k:
    s_cmp_eq_u32 s47, 14
    s_cbranch_scc0 L_nosw
    s_mov_b32 s16, s20
    s_mov_b32 s17, s21
    s_mov_b32 s44, s22
    v_mov_b32 v1, v5
    v_mov_b32 v2, v5
    v_mov_b32 v3, v5
    v_mov_b32 v4, v5
L_nosw:
    ds_read_b128 v[56:59], v6
    ds_read_b128 v[60:63], v7
    ds_read_b128 v[64:67], v8
    ds_read_b128 v[68:71], v9
    ds_read_b128 v[72:75], v10
    ds_read_b128 v[76:79], v11
    ds_read_b128 v[80:83], v12
    ds_read_b128 v[84:87], v13
    ds_read_b32 v39, v29
    s_and_b32 s49, s47, 3
    s_cmp_eq_u32 s49, 3
    s_movk_i32 s23, 0x2000
    s_cmovk_i32 s23, 0xa000
    v_add_u32 v6, s23, v6
    v_add_u32 v7, s23, v7
    v_add_u32 v8, s23, v8
    v_add_u32 v9, s23, v9
    v_add_u32 v10, s23, v10
    v_add_u32 v11, s23, v11
    v_add_u32 v12, s23, v12
    v_add_u32 v13, s23, v13
    s_add_u32 m0, s0, 0
    s_xor_b32 s46, s44, 0
    s_bitcmp1_b32 s10, 0
    s_waitcnt vmcnt(7)
    s_cbranch_scc0 L_w1
    s_waitcnt vmcnt(5)
L_w1:
    buffer_load_dwordx4 v1, s[16:19], s46 offen nt lds
    s_waitcnt lgkmcnt(8)
    v_mfma_f32_32x32x16_bf16 v[88:103], v[56:59], a[0:3], 0
    s_waitcnt lgkmcnt(7)
    v_mfma_f32_32x32x16_bf16 v[88:103], v[60:63], a[4:7], v[88:103]
    s_waitcnt lgkmcnt(6)
    v_mfma_f32_32x32x16_bf16 v[88:103], v[64:67], a[8:11], v[88:103]
    s_waitcnt lgkmcnt(5)
    v_mfma_f32_32x32x16_bf16 v[88:103], v[68:71], a[12:15], v[88:103]
    s_add_u32 m0, s0, 1024
    s_xor_b32 s46, s44, 1024
    s_bitcmp1_b32 s10, 1
    s_waitcnt vmcnt(7)
    s_cbranch_scc0 L_w2
    s_waitcnt vmcnt(5)
L_w2:
    buffer_load_dwordx4 v2, s[16:19], s46 offen nt lds
    s_cmp_eq_u32 s6, 1
    s_cbranch_scc0 L_np2
    s_mul_i32 s49, s59, 4352
    s_add_u32 s49, s49, s101
    buffer_store_dword v42, v41, s[80:83], s49 offen sc1
L_np2:
    s_waitcnt lgkmcnt(4)
    v_mfma_f32_32x32x16_bf16 v[88:103], v[72:75], a[16:19], v[88:103]
    s_waitcnt lgkmcnt(3)
    v_mfma_f32_32x32x16_bf16 v[88:103], v[76:79], a[20:23], v[88:103]
    s_waitcnt lgkmcnt(2)
    v_mfma_f32_32x32x16_bf16 v[88:103], v[80:83], a[24:27], v[88:103]
    s_waitcnt lgkmcnt(1)
    v_mfma_f32_32x32x16_bf16 v[88:103], v[84:87], a[28:31], v[88:103]
    s_add_u32 m0, s0, 2048
    s_xor_b32 s46, s44, 2048
    s_bitcmp1_b32 s10, 2
    s_waitcnt vmcnt(7)
    s_cbranch_scc0 L_w3
    s_waitcnt vmcnt(5)
L_w3:
    buffer_load_dwordx4 v3, s[16:19], s46 offen nt lds
    s_bitcmp1_b32 s89, 1
    s_cbranch_scc0 L_prk
    s_add_u32 s101, s101, 128
    s_sub_u32 s59, s59, 32
    s_and_b32 s59, s59, 255
    s_add_u32 s87, s87, 1
    s_lshr_b32 s85, s59, 3
    s_mul_i32 s85, s85, 2
    s_add_u32 s85, s85, 1
    s_cmp_lt_u32 s59, s86
    s_cselect_b32 s85, s85, 99
    s_and_b32 s49, s87, 7
    s_mul_i32 s92, s49, 4352
    s_add_u32 s92, s92, s88
    s_add_u32 s92, s92, s101
L_prk:
    s_nop 3
    v_max3_f32 v22, v88, v89, v90
    v_max3_f32 v23, v91, v92, v93
    v_max3_f32 v22, v22, v94, v95
    v_max3_f32 v23, v23, v96, v97
    v_max3_f32 v22, v22, v98, v99
    v_max3_f32 v23, v23, v100, v101
    v_max3_f32 v22, v22, v102, v103
    v_max_f32 v22, v22, v23
    v_mov_b32 v23, v22
    s_nop 1
    v_permlane32_swap_b32 v22, v23
    s_nop 1
    v_max_f32 v22, v22, v23
    ds_write_b32 v24, v22
    ds_read_b32 v39, v29
    v_xor_b32 v24, 512, v24
    s_add_u32 m0, s0, 3072
    s_xor_b32 s46, s44, 3072
    s_bitcmp1_b32 s10, 3
    s_waitcnt vmcnt(7)
    s_cbranch_scc0 L_w4
    s_waitcnt vmcnt(5)
L_w4:
    buffer_load_dwordx4 v4, s[16:19], s46 offen nt lds
    s_cmp_eq_u32 s6, 3
    s_cbranch_scc0 L_np4
    s_mul_i32 s49, s59, 4352
    s_add_u32 s49, s49, s101
    buffer_store_dword v42, v41, s[80:83], s49 offen sc1
L_np4:
    s_waitcnt lgkmcnt(1)
    s_barrier
    ds_read_b128 v[32:35], v25
    v_xor_b32 v25, 512, v25
    s_waitcnt lgkmcnt(0)
    s_cmp_eq_u32 s47, 12
    s_cbranch_scc0 L_noef
    s_buffer_load_dwordx4 s[76:79], s[28:31], s45
L_noef:
    s_and_b32 s49, s89, 0x80000001
    s_cbranch_scc0 L_lkk
    s_bitcmp1_b32 s89, 0
    s_cbranch_scc0 L_vtk
    s_load_dword s84, s[80:81], s92 glc
    s_branch L_lkk
L_vtk:
    s_cmp_eq_u32 s84, s7
    s_cselect_b32 s49, 1, 0
    v_mov_b32 v40, s49
    ds_write_b32 v30, v40
L_lkk:
    v_max3_f32 v22, v32, v33, v18
    v_max3_f32 v22, v34, v35, v22
    v_sub_f32 v20, v18, v22
    v_mul_f32 v20, s48, v20
    v_exp_f32 v20, v20
    v_mov_b32 v18, v22
    v_mul_f32 v21, s48, v22
    v_fma_f32 v88, v88, s48, -v21
    v_fma_f32 v89, v89, s48, -v21
    v_fma_f32 v90, v90, s48, -v21
    v_fma_f32 v91, v91, s48, -v21
    v_fma_f32 v92, v92, s48, -v21
    v_fma_f32 v93, v93, s48, -v21
    v_fma_f32 v94, v94, s48, -v21
    v_fma_f32 v95, v95, s48, -v21
    v_fma_f32 v96, v96, s48, -v21
    v_fma_f32 v97, v97, s48, -v21
    v_fma_f32 v98, v98, s48, -v21
    v_fma_f32 v99, v99, s48, -v21
    v_fma_f32 v100, v100, s48, -v21
    v_fma_f32 v101, v101, s48, -v21
    v_fma_f32 v102, v102, s48, -v21
    v_fma_f32 v103, v103, s48, -v21
    s_add_u32 m0, s0, 4096
    s_xor_b32 s46, s44, 16384
    s_bitcmp1_b32 s10, 4
    s_waitcnt vmcnt(7)
    s_cbranch_scc0 L_w5
    s_waitcnt vmcnt(5)
L_w5:
    buffer_load_dwordx4 v1, s[16:19], s46 offen nt lds
    v_exp_f32 v88, v88
    v_exp_f32 v89, v89
    v_exp_f32 v90, v90
    v_exp_f32 v91, v91
    v_exp_f32 v92, v92
    v_exp_f32 v93, v93
    v_exp_f32 v94, v94
    v_exp_f32 v95, v95
    v_exp_f32 v96, v96
    v_exp_f32 v97, v97
    v_exp_f32 v98, v98
    v_exp_f32 v99, v99
    v_exp_f32 v100, v100
    v_exp_f32 v101, v101
    v_exp_f32 v102, v102
    v_exp_f32 v103, v103
    s_add_u32 m0, s0, 5120
    s_xor_b32 s46, s44, 17408
    s_bitcmp1_b32 s10, 5
    s_waitcnt vmcnt(7)
    s_cbranch_scc0 L_w6
    s_waitcnt vmcnt(5)
L_w6:
    buffer_load_dwordx4 v2, s[16:19], s46 offen nt lds
    s_cmp_eq_u32 s6, 5
    s_cbranch_scc0 L_np6
    s_mul_i32 s49, s59, 4352
    s_add_u32 s49, s49, s101
    buffer_store_dword v42, v41, s[80:83], s49 offen sc1
L_np6:
    v_mul_f32 v19, v19, v20
    v_cvt_pk_bf16_f32 v48, v88, v89
    v_cvt_pk_bf16_f32 v49, v90, v91
    v_cvt_pk_bf16_f32 v50, v92, v93
    v_cvt_pk_bf16_f32 v51, v94, v95
    v_cvt_pk_bf16_f32 v52, v96, v97
    v_cvt_pk_bf16_f32 v53, v98, v99
    v_cvt_pk_bf16_f32 v54, v100, v101
    v_cvt_pk_bf16_f32 v55, v102, v103
    s_lshl_b32 s1, s47, 3
    s_set_gpr_idx_on s1, gpr_idx(DST)
    v_mov_b32 v120, v48
    v_mov_b32 v121, v49
    v_mov_b32 v122, v50
    v_mov_b32 v123, v51
    v_mov_b32 v124, v52
    v_mov_b32 v125, v53
    v_mov_b32 v126, v54
    v_mov_b32 v127, v55
    s_set_gpr_idx_idx s47
    v_mov_b32 v104, v20
    s_set_gpr_idx_off
    s_add_u32 m0, s0, 6144
    s_xor_b32 s46, s44, 18432
    s_bitcmp1_b32 s10, 6
    s_waitcnt vmcnt(7)
    s_cbranch_scc0 L_w7
    s_waitcnt vmcnt(5)
L_w7:
    buffer_load_dwordx4 v3, s[16:19], s46 offen nt lds
    s_bitcmp1_b32 s89, 31
    s_cbranch_scc0 L_pkk
    ds_read_b128 v[44:47], v29
    s_waitcnt lgkmcnt(0)
    v_add3_u32 v44, v44, v45, v46
    v_add_u32 v44, v44, v47
    s_nop 0
    v_readfirstlane_b32 s3, v44
    s_nop 1
    s_lshl_b32 s49, s3, 3
    s_lshr_b64 s[10:11], s[12:13], s49
L_pkk:
    v_add_f32 v22, v88, v89
    v_add_f32 v23, v90, v91
    v_add_f32 v22, v22, v92
    v_add_f32 v23, v23, v93
    v_add_f32 v22, v22, v94
    v_add_f32 v23, v23, v95
    v_add_f32 v22, v22, v96
    v_add_f32 v23, v23, v97
    v_add_f32 v22, v22, v98
    v_add_f32 v23, v23, v99
    v_add_f32 v22, v22, v100
    v_add_f32 v23, v23, v101
    v_add_f32 v22, v22, v102
    v_add_f32 v23, v23, v103
    v_add_f32 v19, v19, v22
    v_add_f32 v19, v19, v23
    s_add_u32 m0, s0, 7168
    s_xor_b32 s46, s44, 19456
    s_bitcmp1_b32 s10, 7
    s_waitcnt vmcnt(7)
    s_cbranch_scc0 L_w8
    s_waitcnt vmcnt(5)
L_w8:
    buffer_load_dwordx4 v4, s[16:19], s46 offen nt lds
    s_cmp_eq_u32 s6, 7
    s_cbranch_scc0 L_np8
    s_mul_i32 s49, s59, 4352
    s_add_u32 s49, s49, s101
    buffer_store_dword v42, v41, s[80:83], s49 offen sc1
L_np8:
    s_mov_b32 s6, s85
    s_mov_b32 s85, 99
    s_lshl_b32 s49, s89, 31
    s_bfe_u32 s89, s89, 0x1e0001
    s_or_b32 s89, s89, s49
    s_add_u32 s44, s44, 131072
    s_add_u32 s100, s100, 8192
    s_and_b32 s100, s100, 0x6000
    s_add_u32 s0, s43, s100
    s_add_u32 s47, s47, 1
    s_cmp_lt_u32 s47, 16
    s_cbranch_scc1 L_k
    ds_write_b32 v27, v19
    ds_write_b128 v16, v[120:123]
    ds_write_b128 v16, v[124:127] offset:1024
    v_xor_b32 v16, 8192, v16
    v_mov_b32 v88, 0
    v_mov_b32 v89, 0
    v_mov_b32 v90, 0
    v_mov_b32 v91, 0
    v_mov_b32 v92, 0
    v_mov_b32 v93, 0
    v_mov_b32 v94, 0
    v_mov_b32 v95, 0
    v_mov_b32 v96, 0
    v_mov_b32 v97, 0
    v_mov_b32 v98, 0
    v_mov_b32 v99, 0
    v_mov_b32 v100, 0
    v_mov_b32 v101, 0
    v_mov_b32 v102, 0
    v_mov_b32 v103, 0
    s_mov_b32 s47, 0
    s_mov_b32 s12, 0x115577ff
    s_mov_b32 s13, 0x0
    s_waitcnt lgkmcnt(0)
L_v:
    s_waitcnt lgkmcnt(1)
    s_barrier
    ds_read_b128 a[0:3], v17 offset:0
    ds_read_b64_tr_b16 v[56:57], v14 offset:0
    ds_read_b64_tr_b16 v[58:59], v14 offset:2048
    ds_read_b128 a[4:7], v17 offset:1024
    ds_read_b64_tr_b16 v[60:61], v14 offset:4096
    ds_read_b64_tr_b16 v[62:63], v14 offset:6144
    ds_read_b128 a[8:11], v17 offset:2048
    ds_read_b64_tr_b16 v[64:65], v14 offset:32768
    ds_read_b64_tr_b16 v[66:67], v14 offset:34816
    ds_read_b128 a[12:15], v17 offset:3072
    ds_read_b64_tr_b16 v[68:69], v14 offset:36864
    ds_read_b64_tr_b16 v[70:71], v14 offset:38912
    s_add_u32 m0, s0, 0
    s_xor_b32 s46, s44, 0
    s_bitcmp1_b32 s10, 0
    s_waitcnt vmcnt(7)
    s_cbranch_scc0 L_w9
    s_waitcnt vmcnt(4)
L_w9:
    buffer_load_dwordx4 v1, s[16:19], s46 offen nt lds
    s_waitcnt lgkmcnt(9)
    ds_read_b128 a[16:19], v17 offset:4096
    ds_read_b64_tr_b16 v[72:73], v15 offset:0
    ds_read_b64_tr_b16 v[74:75], v15 offset:2048
    v_mfma_f32_32x32x16_bf16 v[88:103], v[56:59], a[0:3], v[88:103]
    s_waitcnt lgkmcnt(9)
    ds_read_b128 a[20:23], v17 offset:5120
    ds_read_b64_tr_b16 v[76:77], v15 offset:4096
    ds_read_b64_tr_b16 v[78:79], v15 offset:6144
    v_mfma_f32_32x32x16_bf16 v[88:103], v[60:63], a[4:7], v[88:103]
    s_waitcnt lgkmcnt(9)
    ds_read_b128 a[24:27], v17 offset:6144
    ds_read_b64_tr_b16 v[80:81], v15 offset:32768
    ds_read_b64_tr_b16 v[82:83], v15 offset:34816
    v_mfma_f32_32x32x16_bf16 v[88:103], v[64:67], a[8:11], v[88:103]
    s_waitcnt lgkmcnt(9)
    ds_read_b128 a[28:31], v17 offset:7168
    ds_read_b64_tr_b16 v[84:85], v15 offset:36864
    ds_read_b64_tr_b16 v[86:87], v15 offset:38912
    v_mfma_f32_32x32x16_bf16 v[88:103], v[68:71], a[12:15], v[88:103]
    s_add_u32 m0, s0, 1024
    s_xor_b32 s46, s44, 1024
    s_bitcmp1_b32 s10, 1
    s_waitcnt vmcnt(7)
    s_cbranch_scc0 L_w10
    s_waitcnt vmcnt(4)
L_w10:
    buffer_load_dwordx4 v2, s[16:19], s46 offen nt lds
    s_cmp_eq_u32 s6, 1
    s_cbranch_scc0 L_np10
    s_mul_i32 s49, s59, 4352
    s_add_u32 s49, s49, s101
    buffer_store_dword v42, v41, s[80:83], s49 offen sc1
L_np10:
    s_waitcnt lgkmcnt(9)
    v_mfma_f32_32x32x16_bf16 v[88:103], v[72:75], a[16:19], v[88:103]
    s_waitcnt lgkmcnt(6)
    v_mfma_f32_32x32x16_bf16 v[88:103], v[76:79], a[20:23], v[88:103]
    s_waitcnt lgkmcnt(3)
    v_mfma_f32_32x32x16_bf16 v[88:103], v[80:83], a[24:27], v[88:103]
    s_waitcnt lgkmcnt(0)
    v_mfma_f32_32x32x16_bf16 v[88:103], v[84:87], a[28:31], v[88:103]
    s_add_u32 m0, s0, 2048
    s_xor_b32 s46, s44, 2048
    s_bitcmp1_b32 s10, 2
    s_waitcnt vmcnt(7)
    s_cbranch_scc0 L_w11
    s_waitcnt vmcnt(4)
L_w11:
    buffer_load_dwordx4 v3, s[16:19], s46 offen nt lds
    s_and_b32 s49, s89, 0x80000001
    s_cbranch_scc0 L_lkv
    s_bitcmp1_b32 s89, 0
    s_cbranch_scc0 L_vtv
    s_load_dword s84, s[80:81], s92 glc
    s_branch L_lkv
L_vtv:
    s_cmp_eq_u32 s84, s7
    s_cselect_b32 s49, 1, 0
    v_mov_b32 v40, s49
    ds_write_b32 v30, v40
L_lkv:
    s_lshl_b32 s1, s47, 3
    s_set_gpr_idx_on s1, gpr_idx(SRC0)
    v_mov_b32 v48, v128
    v_mov_b32 v49, v129
    v_mov_b32 v50, v130
    v_mov_b32 v51, v131
    v_mov_b32 v52, v132
    v_mov_b32 v53, v133
    v_mov_b32 v54, v134
    v_mov_b32 v55, v135
    s_set_gpr_idx_idx s47
    v_mov_b32 v20, v105
    s_set_gpr_idx_off
    ds_write_b128 v16, v[48:51]
    ds_write_b128 v16, v[52:55] offset:1024
    v_xor_b32 v16, 8192, v16
    v_xor_b32 v17, 8192, v17
    s_and_b32 s49, s47, 3
    s_cmp_eq_u32 s49, 3
    s_movk_i32 s23, 0x2000
    s_cmovk_i32 s23, 0xa000
    v_add_u32 v14, s23, v14
    v_add_u32 v15, s23, v15
    s_add_u32 m0, s0, 3072
    s_xor_b32 s46, s44, 3072
    s_bitcmp1_b32 s10, 3
    s_waitcnt vmcnt(7)
    s_cbranch_scc0 L_w12
    s_waitcnt vmcnt(4)
L_w12:
    buffer_load_dwordx4 v4, s[16:19], s46 offen nt lds
    s_cmp_eq_u32 s6, 3
    s_cbranch_scc0 L_np12
    s_mul_i32 s49, s59, 4352
    s_add_u32 s49, s49, s101
    buffer_store_dword v42, v41, s[80:83], s49 offen sc1
L_np12:
    s_bitcmp1_b32 s89, 1
    s_cbranch_scc0 L_prv
    s_add_u32 s101, s101, 128
    s_sub_u32 s59, s59, 32
    s_and_b32 s59, s59, 255
    s_add_u32 s87, s87, 1
    s_lshr_b32 s85, s59, 3
    s_mul_i32 s85, s85, 2
    s_add_u32 s85, s85, 1
    s_cmp_lt_u32 s59, s86
    s_cselect_b32 s85, s85, 99
    s_and_b32 s49, s87, 7
    s_mul_i32 s92, s49, 4352
    s_add_u32 s92, s92, s88
    s_add_u32 s92, s92, s101
L_prv:
    s_add_u32 m0, s0, 4096
    s_xor_b32 s46, s44, 16384
    s_bitcmp1_b32 s10, 4
    s_waitcnt vmcnt(7)
    s_cbranch_scc0 L_w13
    s_waitcnt vmcnt(4)
L_w13:
    buffer_load_dwordx4 v1, s[16:19], s46 offen nt lds
    ds_read_b128 v[44:47], v29
    v_mul_f32 v88, v88, v20
    v_mul_f32 v89, v89, v20
    v_mul_f32 v90, v90, v20
    v_mul_f32 v91, v91, v20
    v_mul_f32 v92, v92, v20
    v_mul_f32 v93, v93, v20
    v_mul_f32 v94, v94, v20
    v_mul_f32 v95, v95, v20
    v_mul_f32 v96, v96, v20
    v_mul_f32 v97, v97, v20
    v_mul_f32 v98, v98, v20
    v_mul_f32 v99, v99, v20
    v_mul_f32 v100, v100, v20
    v_mul_f32 v101, v101, v20
    v_mul_f32 v102, v102, v20
    v_mul_f32 v103, v103, v20
    s_bitcmp1_b32 s89, 31
    s_cbranch_scc0 L_pkv
    s_waitcnt lgkmcnt(0)
    v_add3_u32 v44, v44, v45, v46
    v_add_u32 v44, v44, v47
    s_nop 0
    v_readfirstlane_b32 s3, v44
    s_nop 1
    s_lshl_b32 s49, s3, 3
    s_lshr_b64 s[10:11], s[12:13], s49
L_pkv:
    s_add_u32 m0, s0, 5120
    s_xor_b32 s46, s44, 17408
    s_bitcmp1_b32 s10, 5
    s_waitcnt vmcnt(7)
    s_cbranch_scc0 L_w14
    s_waitcnt vmcnt(4)
L_w14:
    buffer_load_dwordx4 v2, s[16:19], s46 offen nt lds
    s_cmp_eq_u32 s6, 5
    s_cbranch_scc0 L_np14
    s_mul_i32 s49, s59, 4352
    s_add_u32 s49, s49, s101
    buffer_store_dword v42, v41, s[80:83], s49 offen sc1
L_np14:
    s_cmp_eq_u32 s47, 3
    s_cbranch_scc0 L_nomisc
    v_add_u32 v37, 148480, v26
    ds_read_b128 v[32:35], v37
    s_waitcnt lgkmcnt(0)
    v_add_f32 v32, v32, v33
    v_add_f32 v34, v34, v35
    v_add_f32 v19, v32, v34
    v_mov_b32 v22, v19
    s_mov_b32 vcc_lo, 0
    s_mov_b32 vcc_hi, -1
    v_permlane32_swap_b32 v22, v19
    s_nop 1
    v_add_f32 v19, v19, v22
    v_cndmask_b32 v130, v18, v19, vcc
    v_mov_b32 v123, s52
    v_mov_b32 v127, s52
    v_mov_b32 v131, s52
    s_xor_b32 s51, s42, s40
    s_cmp_eq_u32 s51, 2
    s_cselect_b32 s76, s77, s76
    s_cmp_eq_u32 s51, 3
    s_cselect_b32 s76, s78, s76
    s_cmp_eq_u32 s79, s93
    s_cselect_b32 s95, 2, 1
    s_xor_b32 s76, s76, 0x5bd1e995
    s_add_u32 s76, s76, 1
    s_cmp_eq_u32 s76, s52
    s_cselect_b32 s95, s95, 0
    s_cmp_eq_u32 s51, 0
    s_cselect_b32 s95, 3, s95
L_nomisc:
    s_add_u32 m0, s0, 6144
    s_xor_b32 s46, s44, 18432
    s_bitcmp1_b32 s10, 6
    s_waitcnt vmcnt(7)
    s_cbranch_scc0 L_w15
    s_waitcnt vmcnt(4)
L_w15:
    buffer_load_dwordx4 v3, s[16:19], s46 offen nt lds
    s_add_u32 m0, s0, 7168
    s_xor_b32 s46, s44, 19456
    s_bitcmp1_b32 s10, 7
    s_waitcnt vmcnt(7)
    s_cbranch_scc0 L_w16
    s_waitcnt vmcnt(4)
L_w16:
    buffer_load_dwordx4 v4, s[16:19], s46 offen nt lds
    s_cmp_eq_u32 s6, 7
    s_cbranch_scc0 L_np16
    s_mul_i32 s49, s59, 4352
    s_add_u32 s49, s49, s101
    buffer_store_dword v42, v41, s[80:83], s49 offen sc1
L_np16:
    s_mov_b32 s6, s85
    s_mov_b32 s85, 99
    s_lshl_b32 s49, s89, 31
    s_bfe_u32 s89, s89, 0x1e0001
    s_or_b32 s89, s89, s49
    s_add_u32 s44, s44, 131072
    s_add_u32 s100, s100, 8192
    s_and_b32 s100, s100, 0x6000
    s_add_u32 s0, s43, s100
    s_add_u32 s47, s47, 1
    s_cmp_lt_u32 s47, 14
    s_cbranch_scc1 L_v
    s_waitcnt lgkmcnt(0)
    s_barrier
    v_lshlrev_b32 v38, 7, v36
    s_cmp_eq_u32 s42, s40
    s_cselect_b32 exec_lo, 1, 0xffffff
    s_mov_b32 exec_hi, 0
    s_mov_b32 m0, 147456
    s_cselect_b32 s49, s45, s96
    buffer_load_dword v38, s[28:31], s49 offen lds
    s_mov_b64 exec, -1
    ds_write_b128 v16, v[240:243]
    ds_write_b128 v16, v[244:247] offset:1024
    ds_read_b128 a[0:3], v17 offset:0
    ds_read_b64_tr_b16 v[56:57], v14 offset:0
    ds_read_b64_tr_b16 v[58:59], v14 offset:2048
    ds_read_b128 a[4:7], v17 offset:1024
    ds_read_b64_tr_b16 v[60:61], v14 offset:4096
    ds_read_b64_tr_b16 v[62:63], v14 offset:6144
    ds_read_b128 a[8:11], v17 offset:2048
    ds_read_b64_tr_b16 v[64:65], v14 offset:32768
    ds_read_b64_tr_b16 v[66:67], v14 offset:34816
    ds_read_b128 a[12:15], v17 offset:3072
    ds_read_b64_tr_b16 v[68:69], v14 offset:36864
    ds_read_b64_tr_b16 v[70:71], v14 offset:38912
    s_waitcnt lgkmcnt(9)
    ds_read_b128 a[16:19], v17 offset:4096
    ds_read_b64_tr_b16 v[72:73], v15 offset:0
    ds_read_b64_tr_b16 v[74:75], v15 offset:2048
    v_mfma_f32_32x32x16_bf16 v[88:103], v[56:59], a[0:3], v[88:103]
    s_waitcnt lgkmcnt(9)
    ds_read_b128 a[20:23], v17 offset:5120
    ds_read_b64_tr_b16 v[76:77], v15 offset:4096
    ds_read_b64_tr_b16 v[78:79], v15 offset:6144
    v_mfma_f32_32x32x16_bf16 v[88:103], v[60:63], a[4:7], v[88:103]
    s_waitcnt lgkmcnt(9)
    ds_read_b128 a[24:27], v17 offset:6144
    ds_read_b64_tr_b16 v[80:81], v15 offset:32768
    ds_read_b64_tr_b16 v[82:83], v15 offset:34816
    v_mfma_f32_32x32x16_bf16 v[88:103], v[64:67], a[8:11], v[88:103]
    s_waitcnt lgkmcnt(9)
    ds_read_b128 a[28:31], v17 offset:7168
    ds_read_b64_tr_b16 v[84:85], v15 offset:36864
    ds_read_b64_tr_b16 v[86:87], v15 offset:38912
    v_mfma_f32_32x32x16_bf16 v[88:103], v[68:71], a[12:15], v[88:103]
    s_waitcnt lgkmcnt(9)
    v_mfma_f32_32x32x16_bf16 v[88:103], v[72:75], a[16:19], v[88:103]
    s_waitcnt lgkmcnt(6)
    v_mfma_f32_32x32x16_bf16 v[88:103], v[76:79], a[20:23], v[88:103]
    s_waitcnt lgkmcnt(3)
    v_mfma_f32_32x32x16_bf16 v[88:103], v[80:83], a[24:27], v[88:103]
    s_waitcnt lgkmcnt(0)
    v_mfma_f32_32x32x16_bf16 v[88:103], v[84:87], a[28:31], v[88:103]
    v_xor_b32 v17, 8192, v17
    s_nop 10
    v_mul_f32 v88, v88, v119
    v_mul_f32 v89, v89, v119
    v_mul_f32 v90, v90, v119
    v_mul_f32 v91, v91, v119
    v_mul_f32 v92, v92, v119
    v_mul_f32 v93, v93, v119
    v_mul_f32 v94, v94, v119
    v_mul_f32 v95, v95, v119
    v_mul_f32 v96, v96, v119
    v_mul_f32 v97, v97, v119
    v_mul_f32 v98, v98, v119
    v_mul_f32 v99, v99, v119
    v_mul_f32 v100, v100, v119
    v_mul_f32 v101, v101, v119
    v_mul_f32 v102, v102, v119
    v_mul_f32 v103, v103, v119
    s_waitcnt vmcnt(5)
    s_barrier
    ds_read_b128 a[0:3], v17 offset:0
    ds_read_b64_tr_b16 v[56:57], v14 offset:8192
    ds_read_b64_tr_b16 v[58:59], v14 offset:10240
    ds_read_b128 a[8:11], v17 offset:2048
    ds_read_b64_tr_b16 v[64:65], v14 offset:40960
    ds_read_b64_tr_b16 v[66:67], v14 offset:43008
    ds_read_b128 a[16:19], v17 offset:4096
    ds_read_b64_tr_b16 v[72:73], v15 offset:8192
    ds_read_b64_tr_b16 v[74:75], v15 offset:10240
    ds_read_b128 a[24:27], v17 offset:6144
    ds_read_b64_tr_b16 v[80:81], v15 offset:40960
    ds_read_b64_tr_b16 v[82:83], v15 offset:43008
    s_waitcnt lgkmcnt(9)
    ds_read_b128 a[4:7], v17 offset:1024
    v_mfma_f32_32x32x16_bf16 v[88:103], v[56:59], a[0:3], v[88:103]
    s_waitcnt lgkmcnt(7)
    ds_read_b128 a[12:15], v17 offset:3072
    v_mfma_f32_32x32x16_bf16 v[88:103], v[64:67], a[8:11], v[88:103]
    s_waitcnt lgkmcnt(5)
    ds_read_b128 a[20:23], v17 offset:5120
    v_mfma_f32_32x32x16_bf16 v[88:103], v[72:75], a[16:19], v[88:103]
    s_waitcnt lgkmcnt(3)
    ds_read_b128 a[28:31], v17 offset:7168
    v_mfma_f32_32x32x16_bf16 v[88:103], v[80:83], a[24:27], v[88:103]
    s_cmp_eq_u32 s95, 3
    s_waitcnt vmcnt(1)
    s_barrier
    ds_read_b64_tr_b16 v[60:61], v14 offset:12288
    ds_read_b64_tr_b16 v[62:63], v14 offset:14336
    ds_read_b64_tr_b16 v[68:69], v14 offset:45056
    ds_read_b64_tr_b16 v[70:71], v14 offset:47104
    ds_read_b64_tr_b16 v[76:77], v15 offset:12288
    ds_read_b64_tr_b16 v[78:79], v15 offset:14336
    ds_read_b64_tr_b16 v[84:85], v15 offset:45056
    ds_read_b64_tr_b16 v[86:87], v15 offset:47104
    s_cbranch_scc1 L_recv
    s_waitcnt lgkmcnt(6)
    v_mfma_f32_32x32x16_bf16 v[88:103], v[60:63], a[4:7], v[88:103]
    s_waitcnt lgkmcnt(4)
    v_mfma_f32_32x32x16_bf16 v[88:103], v[68:71], a[12:15], v[88:103]
    s_waitcnt lgkmcnt(2)
    v_mfma_f32_32x32x16_bf16 v[88:103], v[76:79], a[20:23], v[88:103]
    s_waitcnt lgkmcnt(0)
    v_mfma_f32_32x32x16_bf16 v[88:103], v[84:87], a[28:31], v[88:103]
    s_cmp_eq_u32 s95, 2
    s_cbranch_scc0 L_slow
    s_nop 9
    v_cvt_pk_bf16_f32 v120, v88, v89
    v_cvt_pk_bf16_f32 v121, v90, v91
    v_cvt_pk_bf16_f32 v122, v92, v93
    buffer_store_dwordx4 v[120:123], v26, s[28:31], s96 offen offset:0
    v_cvt_pk_bf16_f32 v124, v94, v95
    v_cvt_pk_bf16_f32 v125, v96, v97
    v_cvt_pk_bf16_f32 v126, v98, v99
    buffer_store_dwordx4 v[124:127], v26, s[28:31], s96 offen offset:1024
    v_cvt_pk_bf16_f32 v128, v100, v101
    v_cvt_pk_bf16_f32 v129, v102, v103
    buffer_store_dwordx4 v[128:131], v26, s[28:31], s96 offen offset:2048
    s_endpgm
L_slow:
    s_nop 9
    v_cvt_pk_bf16_f32 v120, v88, v89
    v_cvt_pk_bf16_f32 v121, v90, v91
    v_cvt_pk_bf16_f32 v122, v92, v93
    buffer_store_dwordx4 v[120:123], v26, s[28:31], s96 offen offset:0 sc1
    v_cvt_pk_bf16_f32 v124, v94, v95
    v_cvt_pk_bf16_f32 v125, v96, v97
    v_cvt_pk_bf16_f32 v126, v98, v99
    buffer_store_dwordx4 v[124:127], v26, s[28:31], s96 offen offset:1024 sc1
    v_cvt_pk_bf16_f32 v128, v100, v101
    v_cvt_pk_bf16_f32 v129, v102, v103
    buffer_store_dwordx4 v[128:131], v26, s[28:31], s96 offen offset:2048 sc1
    s_cmp_eq_u32 s95, 1
    s_cbranch_scc1 L_fin
    s_lshl_b32 s49, s42, 2
    s_add_u32 s49, s49, s40
    s_lshl_b32 s49, 1, s49
    v_mov_b32 v37, s49
    s_lshl_b32 s49, s41, 2
    s_waitcnt vmcnt(0)
    s_mov_b64 exec, 1
    buffer_atomic_or v37, off, s[36:39], s49 sc1
    s_branch L_fin
L_recv:
    buffer_load_dwordx4 v[136:139], v26, s[28:31], s96 offen offset:0 sc1
    buffer_load_dwordx4 v[140:143], v26, s[28:31], s96 offen offset:1024 sc1
    buffer_load_dwordx4 v[144:147], v26, s[28:31], s96 offen offset:2048 sc1
    buffer_load_dwordx4 v[148:151], v26, s[28:31], s97 offen offset:0 sc1
    buffer_load_dwordx4 v[152:155], v26, s[28:31], s97 offen offset:1024 sc1
    buffer_load_dwordx4 v[156:159], v26, s[28:31], s97 offen offset:2048 sc1
    buffer_load_dwordx4 v[160:163], v26, s[28:31], s98 offen offset:0 sc1
    buffer_load_dwordx4 v[164:167], v26, s[28:31], s98 offen offset:1024 sc1
    buffer_load_dwordx4 v[168:171], v26, s[28:31], s98 offen offset:2048 sc1
    s_waitcnt lgkmcnt(6)
    v_mfma_f32_32x32x16_bf16 v[88:103], v[60:63], a[4:7], v[88:103]
    s_waitcnt lgkmcnt(4)
    v_mfma_f32_32x32x16_bf16 v[88:103], v[68:71], a[12:15], v[88:103]
    s_waitcnt lgkmcnt(2)
    v_mfma_f32_32x32x16_bf16 v[88:103], v[76:79], a[20:23], v[88:103]
    s_waitcnt lgkmcnt(0)
    v_mfma_f32_32x32x16_bf16 v[88:103], v[84:87], a[28:31], v[88:103]
    s_mov_b32 s55, 7
    s_mov_b32 s99, 0
    s_mov_b32 s47, 0
    s_mov_b32 s51, 3
L_round:
    s_bitcmp1_b32 s55, 0
    s_cbranch_scc0 L_nc0
    s_cmp_gt_u32 s51, 2
    s_cbranch_scc1 L_w60
    s_cmp_gt_u32 s51, 1
    s_cbranch_scc1 L_w30
    s_waitcnt vmcnt(0)
L_w30:
    s_waitcnt vmcnt(3)
L_w60:
    s_waitcnt vmcnt(6)
    v_bitop3_b32 v22, v139, v143, s52 bitop3:0x7e
    v_bitop3_b32 v22, v147, v22, s52 bitop3:0xde
    v_cmp_ne_u32 vcc, 0, v22
    v_mov_b32 v120, v146
    v_mov_b32 v121, v146
    s_cbranch_vccz L_ok0
    s_bitcmp1_b32 s99, 0
    s_cbranch_scc1 L_ok0
    buffer_load_dwordx4 v[136:139], v26, s[28:31], s96 offen offset:0 sc1
    buffer_load_dwordx4 v[140:143], v26, s[28:31], s96 offen offset:1024 sc1
    buffer_load_dwordx4 v[144:147], v26, s[28:31], s96 offen offset:2048 sc1
    s_branch L_nc0
L_ok0:
    s_bitset0_b32 s55, 0
    s_sub_u32 s51, s51, 1
    v_permlane32_swap_b32 v120, v121
    v_lshlrev_b32 v176, 16, v136
    v_and_b32 v177, 0xffff0000, v136
    v_lshlrev_b32 v178, 16, v137
    v_and_b32 v179, 0xffff0000, v137
    v_lshlrev_b32 v180, 16, v138
    v_and_b32 v181, 0xffff0000, v138
    v_lshlrev_b32 v182, 16, v140
    v_and_b32 v183, 0xffff0000, v140
    v_lshlrev_b32 v184, 16, v141
    v_and_b32 v185, 0xffff0000, v141
    v_lshlrev_b32 v186, 16, v142
    v_and_b32 v187, 0xffff0000, v142
    v_lshlrev_b32 v188, 16, v144
    v_and_b32 v189, 0xffff0000, v144
    v_lshlrev_b32 v190, 16, v145
    v_and_b32 v191, 0xffff0000, v145
    s_cmp_eq_u32 s51, 0
    s_cbranch_scc1 L_have
L_nc0:
    s_bitcmp1_b32 s55, 1
    s_cbranch_scc0 L_nc1
    s_cmp_gt_u32 s51, 2
    s_cbranch_scc1 L_w61
    s_cmp_gt_u32 s51, 1
    s_cbranch_scc1 L_w31
    s_waitcnt vmcnt(0)
L_w31:
    s_waitcnt vmcnt(3)
L_w61:
    s_waitcnt vmcnt(6)
    v_bitop3_b32 v22, v151, v155, s53 bitop3:0x7e
    v_bitop3_b32 v22, v159, v22, s53 bitop3:0xde
    v_cmp_ne_u32 vcc, 0, v22
    v_mov_b32 v122, v158
    v_mov_b32 v123, v158
    s_cbranch_vccz L_ok1
    s_bitcmp1_b32 s99, 1
    s_cbranch_scc1 L_ok1
    buffer_load_dwordx4 v[148:151], v26, s[28:31], s97 offen offset:0 sc1
    buffer_load_dwordx4 v[152:155], v26, s[28:31], s97 offen offset:1024 sc1
    buffer_load_dwordx4 v[156:159], v26, s[28:31], s97 offen offset:2048 sc1
    s_branch L_nc1
L_ok1:
    s_bitset0_b32 s55, 1
    s_sub_u32 s51, s51, 1
    v_permlane32_swap_b32 v122, v123
    v_lshlrev_b32 v192, 16, v148
    v_and_b32 v193, 0xffff0000, v148
    v_lshlrev_b32 v194, 16, v149
    v_and_b32 v195, 0xffff0000, v149
    v_lshlrev_b32 v196, 16, v150
    v_and_b32 v197, 0xffff0000, v150
    v_lshlrev_b32 v198, 16, v152
    v_and_b32 v199, 0xffff0000, v152
    v_lshlrev_b32 v200, 16, v153
    v_and_b32 v201, 0xffff0000, v153
    v_lshlrev_b32 v202, 16, v154
    v_and_b32 v203, 0xffff0000, v154
    v_lshlrev_b32 v204, 16, v156
    v_and_b32 v205, 0xffff0000, v156
    v_lshlrev_b32 v206, 16, v157
    v_and_b32 v207, 0xffff0000, v157
    s_cmp_eq_u32 s51, 0
    s_cbranch_scc1 L_have
L_nc1:
    s_bitcmp1_b32 s55, 2
    s_cbranch_scc0 L_nc2
    s_cmp_gt_u32 s51, 2
    s_cbranch_scc1 L_w62
    s_cmp_gt_u32 s51, 1
    s_cbranch_scc1 L_w32
    s_waitcnt vmcnt(0)
L_w32:
    s_waitcnt vmcnt(3)
L_w62:
    s_waitcnt vmcnt(6)
    v_bitop3_b32 v22, v163, v167, s54 bitop3:0x7e
    v_bitop3_b32 v22, v171, v22, s54 bitop3:0xde
    v_cmp_ne_u32 vcc, 0, v22
    v_mov_b32 v124, v170
    v_mov_b32 v125, v170
    s_cbranch_vccz L_ok2
    s_bitcmp1_b32 s99, 2
    s_cbranch_scc1 L_ok2
    buffer_load_dwordx4 v[160:163], v26, s[28:31], s98 offen offset:0 sc1
    buffer_load_dwordx4 v[164:167], v26, s[28:31], s98 offen offset:1024 sc1
    buffer_load_dwordx4 v[168:171], v26, s[28:31], s98 offen offset:2048 sc1
    s_branch L_nc2
L_ok2:
    s_bitset0_b32 s55, 2
    s_sub_u32 s51, s51, 1
    v_permlane32_swap_b32 v124, v125
    v_lshlrev_b32 v208, 16, v160
    v_and_b32 v209, 0xffff0000, v160
    v_lshlrev_b32 v210, 16, v161
    v_and_b32 v211, 0xffff0000, v161
    v_lshlrev_b32 v212, 16, v162
    v_and_b32 v213, 0xffff0000, v162
    v_lshlrev_b32 v214, 16, v164
    v_and_b32 v215, 0xffff0000, v164
    v_lshlrev_b32 v216, 16, v165
    v_and_b32 v217, 0xffff0000, v165
    v_lshlrev_b32 v218, 16, v166
    v_and_b32 v219, 0xffff0000, v166
    v_lshlrev_b32 v220, 16, v168
    v_and_b32 v221, 0xffff0000, v168
    v_lshlrev_b32 v222, 16, v169
    v_and_b32 v223, 0xffff0000, v169
L_nc2:
    s_cmp_eq_u32 s51, 0
    s_cbranch_scc1 L_have
    s_add_u32 s47, s47, 1
    s_and_b32 s49, s47, 63
    s_cbranch_scc1 L_round
    s_cmp_ge_u32 s47, 0x200000
    s_cbranch_scc1 L_fin
    s_lshl_b32 s49, s41, 2
    buffer_load_dword v21, off, s[36:39], s49 sc1
    v_add_u32 v22, 1, v36
    v_xor_b32 v22, s42, v22
    v_lshlrev_b32 v22, 2, v22
    v_add_u32 v22, s40, v22
    s_waitcnt vmcnt(0)
    v_bfe_u32 v21, v21, v22, 1
    v_cmp_ne_u32 vcc, 0, v21
    s_nop 1
    s_and_b32 s99, vcc_lo, 7
    s_cbranch_scc0 L_keep
    s_sub_u32 s49, s52, 1
    s_xor_b32 s49, s49, 0xdbd1e995
    v_mov_b32 v32, s49
    s_sub_u32 s49, s53, 1
    s_xor_b32 s49, s49, 0xdbd1e995
    v_mov_b32 v33, s49
    s_sub_u32 s49, s54, 1
    s_xor_b32 s49, s49, 0xdbd1e995
    v_mov_b32 v34, s49
    s_mov_b64 exec, 1
    buffer_store_dwordx3 v[32:34], off, s[28:31], s45 sc1
    s_mov_b64 exec, -1
L_keep:
    s_bitcmp1_b32 s55, 0
    s_cbranch_scc0 L_ni0
    buffer_load_dwordx4 v[136:139], v26, s[28:31], s96 offen offset:0 sc1
    buffer_load_dwordx4 v[140:143], v26, s[28:31], s96 offen offset:1024 sc1
    buffer_load_dwordx4 v[144:147], v26, s[28:31], s96 offen offset:2048 sc1
L_ni0:
    s_bitcmp1_b32 s55, 1
    s_cbranch_scc0 L_ni1
    buffer_load_dwordx4 v[148:151], v26, s[28:31], s97 offen offset:0 sc1
    buffer_load_dwordx4 v[152:155], v26, s[28:31], s97 offen offset:1024 sc1
    buffer_load_dwordx4 v[156:159], v26, s[28:31], s97 offen offset:2048 sc1
L_ni1:
    s_bitcmp1_b32 s55, 2
    s_cbranch_scc0 L_ni2
    buffer_load_dwordx4 v[160:163], v26, s[28:31], s98 offen offset:0 sc1
    buffer_load_dwordx4 v[164:167], v26, s[28:31], s98 offen offset:1024 sc1
    buffer_load_dwordx4 v[168:171], v26, s[28:31], s98 offen offset:2048 sc1
L_ni2:
    s_branch L_round
L_have:
    v_max3_f32 v22, v120, v122, v124
    v_max_f32 v22, v22, v18
    v_mul_f32 v22, s48, v22
    v_fma_f32 v224, v120, s48, -v22
    v_fma_f32 v226, v122, s48, -v22
    v_fma_f32 v228, v124, s48, -v22
    v_fma_f32 v230, v18, s48, -v22
    v_exp_f32 v224, v224
    v_exp_f32 v226, v226
    v_exp_f32 v228, v228
    v_exp_f32 v230, v230
    s_lshl_b32 s46, s40, 6
    v_mul_f32 v19, v230, v19
    v_fmac_f32 v19, v224, v121
    v_fmac_f32 v19, v226, v123
    v_fmac_f32 v19, v228, v125
    v_rcp_f32 v19, v19
    s_nop 0
    v_mul_f32 v224, v224, v19
    v_mul_f32 v226, v226, v19
    v_mul_f32 v228, v228, v19
    v_mul_f32 v230, v230, v19
    v_pk_mul_f32 v[88:89], v[88:89], v[230:231] op_sel_hi:[1,0]
    v_pk_mul_f32 v[90:91], v[90:91], v[230:231] op_sel_hi:[1,0]
    v_pk_mul_f32 v[92:93], v[92:93], v[230:231] op_sel_hi:[1,0]
    v_pk_mul_f32 v[94:95], v[94:95], v[230:231] op_sel_hi:[1,0]
    v_pk_fma_f32 v[88:89], v[176:177], v[224:225], v[88:89] op_sel_hi:[1,0,1]
    v_pk_fma_f32 v[90:91], v[178:179], v[224:225], v[90:91] op_sel_hi:[1,0,1]
    v_pk_fma_f32 v[92:93], v[180:181], v[224:225], v[92:93] op_sel_hi:[1,0,1]
    v_pk_fma_f32 v[94:95], v[182:183], v[224:225], v[94:95] op_sel_hi:[1,0,1]
    v_pk_fma_f32 v[88:89], v[192:193], v[226:227], v[88:89] op_sel_hi:[1,0,1]
    v_pk_fma_f32 v[90:91], v[194:195], v[226:227], v[90:91] op_sel_hi:[1,0,1]
    v_pk_fma_f32 v[92:93], v[196:197], v[226:227], v[92:93] op_sel_hi:[1,0,1]
    v_pk_fma_f32 v[94:95], v[198:199], v[226:227], v[94:95] op_sel_hi:[1,0,1]
    v_pk_fma_f32 v[88:89], v[208:209], v[228:229], v[88:89] op_sel_hi:[1,0,1]
    v_pk_fma_f32 v[90:91], v[210:211], v[228:229], v[90:91] op_sel_hi:[1,0,1]
    v_pk_fma_f32 v[92:93], v[212:213], v[228:229], v[92:93] op_sel_hi:[1,0,1]
    v_pk_fma_f32 v[94:95], v[214:215], v[228:229], v[94:95] op_sel_hi:[1,0,1]
    v_cvt_pk_bf16_f32 v48, v88, v89
    v_cvt_pk_bf16_f32 v50, v92, v93
    v_cvt_pk_bf16_f32 v49, v90, v91
    v_cvt_pk_bf16_f32 v51, v94, v95
    v_permlane32_swap_b32 v48, v50
    s_nop 0
    v_permlane32_swap_b32 v49, v51
    buffer_store_dwordx4 v[48:51], v28, s[32:35], s46 offen offset:0
    v_pk_mul_f32 v[96:97], v[96:97], v[230:231] op_sel_hi:[1,0]
    v_pk_mul_f32 v[98:99], v[98:99], v[230:231] op_sel_hi:[1,0]
    v_pk_mul_f32 v[100:101], v[100:101], v[230:231] op_sel_hi:[1,0]
    v_pk_mul_f32 v[102:103], v[102:103], v[230:231] op_sel_hi:[1,0]
    v_pk_fma_f32 v[96:97], v[184:185], v[224:225], v[96:97] op_sel_hi:[1,0,1]
    v_pk_fma_f32 v[98:99], v[186:187], v[224:225], v[98:99] op_sel_hi:[1,0,1]
    v_pk_fma_f32 v[100:101], v[188:189], v[224:225], v[100:101] op_sel_hi:[1,0,1]
    v_pk_fma_f32 v[102:103], v[190:191], v[224:225], v[102:103] op_sel_hi:[1,0,1]
    v_pk_fma_f32 v[96:97], v[200:201], v[226:227], v[96:97] op_sel_hi:[1,0,1]
    v_pk_fma_f32 v[98:99], v[202:203], v[226:227], v[98:99] op_sel_hi:[1,0,1]
    v_pk_fma_f32 v[100:101], v[204:205], v[226:227], v[100:101] op_sel_hi:[1,0,1]
    v_pk_fma_f32 v[102:103], v[206:207], v[226:227], v[102:103] op_sel_hi:[1,0,1]
    v_pk_fma_f32 v[96:97], v[216:217], v[228:229], v[96:97] op_sel_hi:[1,0,1]
    v_pk_fma_f32 v[98:99], v[218:219], v[228:229], v[98:99] op_sel_hi:[1,0,1]
    v_pk_fma_f32 v[100:101], v[220:221], v[228:229], v[100:101] op_sel_hi:[1,0,1]
    v_pk_fma_f32 v[102:103], v[222:223], v[228:229], v[102:103] op_sel_hi:[1,0,1]
    v_cvt_pk_bf16_f32 v52, v96, v97
    v_cvt_pk_bf16_f32 v54, v100, v101
    v_cvt_pk_bf16_f32 v53, v98, v99
    v_cvt_pk_bf16_f32 v55, v102, v103
    v_permlane32_swap_b32 v52, v54
    s_nop 0
    v_permlane32_swap_b32 v53, v55
    buffer_store_dwordx4 v[52:55], v28, s[32:35], s46 offen offset:32
L_fin:
L_end:
    s_endpgm
.section .rodata,"a"
.p2align 6
.amdhsa_kernel standalone__gqa_softmax__sampling_kernel
  .amdhsa_next_free_vgpr 280
  .amdhsa_next_free_sgpr 102
  .amdhsa_accum_offset 248
  .amdhsa_group_segment_fixed_size 0
  .amdhsa_kernarg_size 48
  .amdhsa_user_sgpr_count 2
  .amdhsa_user_sgpr_kernarg_segment_ptr 1
  .amdhsa_system_sgpr_workgroup_id_x 1
  .amdhsa_float_denorm_mode_32 3
.end_amdhsa_kernel
```
